```python
import torch

def _softmax(x, axis=-1):
    return torch.softmax(x, dim=axis)
def _gelu(x):
    return torch.nn.functional.gelu(x, approximate="tanh")
def _silu(x):
    return torch.nn.functional.silu(x)
def _sigmoid(x):
    return torch.sigmoid(x)
def _layernorm(x, axis=-1, eps=1e-5):
    m = x.mean(dim=axis, keepdim=True)
    v = x.var(dim=axis, keepdim=True, unbiased=False)
    return (x - m) / torch.sqrt(v + eps)
def _scatter_add(tgt, idx, src, axis=0):
    return tgt.clone().index_add_(axis, idx, src)
def _segment_sum(src, seg, n):
    out = torch.zeros((n,) + src.shape[1:], dtype=src.dtype)
    return out.index_add_(0, seg, src)
def _pad(x, pw):
    flat = tuple(v for pair in reversed(pw) for v in pair)
    return torch.nn.functional.pad(x, flat)

kernel_name = 'gather_scatter__kernel_systems_refs_featgraph__graph'

def setup_inputs():

    _w = (lambda a: (lambda t: t.to(torch.bfloat16) if t.is_floating_point() else t)(torch.as_tensor(a)))
    N, deg, D = 10000, 64, 64
    E = N * deg
    scale = D ** -0.5
    src = (lambda lo, hi, *s: torch.randint(lo, hi, s))(0, N, E).to(torch.int64)
    dst = (lambda lo, hi, *s: torch.randint(lo, hi, s))(0, N, E).to(torch.int64)
    return {
        "x": _w((lambda *s: torch.randn(*s, dtype=torch.bfloat16) * 0.8)(N, D)),
        "src": _w(src),
        "dst": _w(dst),
        "w_q": _w((lambda *s: torch.randn(*s, dtype=torch.bfloat16) * 0.8)(D, D) * scale),
        "w_v": _w((lambda *s: torch.randn(*s, dtype=torch.bfloat16) * 0.05)(D, D) * scale),
    }

def reference(x, src, dst, w_q, w_v):
    N, D = x.shape
    xs = x[src]
    xd = x[dst]
    q = xd @ w_q
    logits = torch.einsum('ed,ed->e', xs, q) * (float(D) ** -0.5)
    alpha = _sigmoid(logits)
    msg = alpha[:, None] * (xs @ w_v)
    return _segment_sum(msg, dst, N)
```

```asm
; @launch grid=(250,1,1) block=(1024,1,1) lds=141056
.amdgcn_target "amdgcn-amd-amdhsa--gfx950"
.text
.globl gather_scatter__kernel_systems_refs_featgraph__graph_kernel
.p2align 8
.type gather_scatter__kernel_systems_refs_featgraph__graph_kernel,@function
gather_scatter__kernel_systems_refs_featgraph__graph_kernel:
s_cmp_ge_u32 s2, 250
s_cbranch_scc1 G_end
s_load_dwordx8 s[48:55], s[0:1], 0
s_load_dwordx8 s[56:63], s[0:1], 32
v_lshrrev_b32 v32, 6, v0
v_and_b32 v17, 63, v0
v_readfirstlane_b32 s17, v32
v_lshlrev_b32 v33, 4, v0
v_lshlrev_b32 v34, 4, v17
s_mul_i32 s3, s2, 10240
v_add_u32 v35, s3, v33
s_and_b32 s43, s2, 7
s_lshr_b32 s44, s2, 3
s_mul_i32 s16, s43, 31
s_min_u32 s34, s43, 2
s_add_u32 s16, s16, s34
s_add_u32 s16, s16, s44
s_mov_b32 s6, 1280000
s_mov_b32 s7, 0x20000
s_mov_b32 s10, 7104000
s_mov_b32 s11, 0x20000
s_mov_b32 s14, 1280000
s_mov_b32 s15, 0x20000
s_mov_b32 s23, 0
v_and_b32 v48, 7, v17
v_lshrrev_b32 v49, 4, v17
v_mov_b32 v6, 0
s_cmp_ge_u32 s17, 10
s_cbranch_scc1 G_helper
s_setprio 3
s_waitcnt lgkmcnt(0)
global_load_dwordx4 v[60:63], v35, s[52:53] nt
global_load_dwordx4 v[64:67], v35, s[50:51] nt
s_mov_b64 s[4:5], s[48:49]
s_mov_b64 s[8:9], s[62:63]
s_mov_b64 s[12:13], s[58:59]
s_mov_b64 s[18:19], s[60:61]
s_branch G_init
G_helper:
v_lshlrev_b32 v50, 1, v49
v_xor_b32 v50, v48, v50
v_and_b32 v51, 0x380, v34
v_lshl_add_u32 v50, v50, 4, v51
s_and_b32 s45, s17, 1
s_lshl_b32 s45, s45, 12
s_waitcnt lgkmcnt(0)
s_mov_b64 s[4:5], s[48:49]
s_mov_b64 s[8:9], s[62:63]
s_mov_b64 s[12:13], s[58:59]
s_mov_b64 s[18:19], s[60:61]
s_mov_b32 s63, 0x20000
s_cmp_lg_u32 s2, 0
s_cbranch_scc1 G_notagw
s_cmp_lg_u32 s17, 15
s_cbranch_scc1 G_notagw
s_memrealtime s[34:35]
s_waitcnt lgkmcnt(0)
s_or_b32 s34, s34, 1
v_mov_b32 v52, s34
v_mov_b32 v53, s35
v_mov_b32 v54, s34
v_mov_b32 v55, s35
s_mov_b64 exec, 0xff
global_store_dwordx4 v34, v[52:55], s[18:19] sc1
s_mov_b64 exec, -1
G_notagw:
s_cmp_ge_u32 s17, 14
s_cselect_b32 s60, s56, s54
s_cselect_b32 s61, s57, s55
s_mov_b32 s34, 24576
s_cselect_b32 s34, 40960, s34
s_mov_b32 s62, 8192
s_mov_b32 s35, s45
s_lshr_b32 s36, s17, 1
s_cmp_lg_u32 s36, 6
s_cbranch_scc1 G_hw
s_mov_b32 s60, s4
s_mov_b32 s61, s5
s_mov_b32 s62, 1280000
s_mov_b32 s34, 32768
s_mul_i32 s35, s16, 5120
s_add_u32 s35, s35, s45
s_branch G_hd
G_hw:
v_mov_b32 v50, v34
G_hd:
s_add_u32 m0, s34, s45
s_nop 0
buffer_load_dwordx4 v50, s[60:63], s35 offen offset:0 lds
buffer_load_dwordx4 v50, s[60:63], s35 offen offset:1024 lds
buffer_load_dwordx4 v50, s[60:63], s35 offen offset:2048 lds
buffer_load_dwordx4 v50, s[60:63], s35 offen offset:3072 lds
s_mov_b32 s34, 6144
s_bitcmp1_b32 s34, s17
s_cbranch_scc0 G_nopf0
s_sub_u32 s35, s17, 11
s_mul_i32 s34, s44, 40000
s_lshl_b32 s35, s35, 13
s_add_u32 s34, s34, s35
v_lshlrev_b32 v50, 7, v17
buffer_load_dword v18, v50, s[4:7], s34 offen
G_nopf0:
G_init:
v_add_u32 v36, 112384, v33
v_mov_b32 v84, 2096944
v_mov_b32 v85, 2096944
v_mov_b32 v86, 2096944
v_mov_b32 v87, 2096944
v_lshlrev_b32 v59, 2, v0
v_add_u32 v59, 111104, v59
ds_write_b128 v36, v[84:87]
s_cmp_ge_u32 s17, 12
s_cbranch_scc1 G_noz
ds_write_b128 v36, v[84:87] offset:16384
s_cmp_ge_u32 s17, 5
s_cbranch_scc1 G_noz
ds_write_b32 v59, v6
G_noz:
s_movk_i32 s24, 512
s_mov_b32 s28, 0xbe38aa3b
s_movk_i32 s29, 1280
s_movk_i32 s25, -40
s_mul_i32 s27, s2, 28416
s_mov_b32 s43, 2096944
v_mov_b32 v39, 1
v_mov_b32 v58, 111104
v_mov_b32 v57, 112384
s_waitcnt lgkmcnt(0)
s_barrier
v_add_u32 v35, 84480, v33
v_mov_b32 v88, 0
v_mov_b32 v89, 0
v_mov_b32 v90, 0
v_mov_b32 v91, 0
ds_write_b128 v35, v[84:87]
s_mul_i32 s26, s17, 2176
s_add_u32 s26, s26, 49152
v_lshlrev_b32 v51, 1, v17
v_and_b32 v51, 48, v51
v_xor_b32 v3, v51, v34
v_add_u32 v3, s26, v3
ds_write_b128 v3, v[88:91]
ds_write_b128 v3, v[88:91] offset:1088
s_cmp_lt_u32 s17, 10
s_cbranch_scc1 G_edges
s_cmp_ge_u32 s17, 14
s_cbranch_scc1 G_z2
ds_write_b128 v35, v[84:87] offset:6144
s_branch G_pb
G_z2:
v_lshlrev_b32 v50, 2, v17
v_add_u32 v50, 83968, v50
ds_write_b32 v50, v88
s_branch G_pb
G_edges:
s_waitcnt vmcnt(1)
v_mul_u32_u24 v76, 0xcccd, v60
v_mul_u32_u24 v77, 0xcccd, v61
v_mul_u32_u24 v78, 0xcccd, v62
v_mul_u32_u24 v79, 0xcccd, v63
v_lshrrev_b32 v76, 21, v76
v_lshrrev_b32 v77, 21, v77
v_lshrrev_b32 v78, 21, v78
v_lshrrev_b32 v79, 21, v79
v_lshl_add_u32 v68, v76, 2, v58
v_lshl_add_u32 v69, v77, 2, v58
v_lshl_add_u32 v70, v78, 2, v58
v_lshl_add_u32 v71, v79, 2, v58
ds_add_rtn_u32 v72, v68, v39
ds_add_rtn_u32 v73, v69, v39
ds_add_rtn_u32 v74, v70, v39
ds_add_rtn_u32 v75, v71, v39
v_lshl_add_u32 v80, v76, 6, v57
v_lshl_add_u32 v81, v77, 6, v57
v_lshl_add_u32 v82, v78, 6, v57
v_lshl_add_u32 v83, v79, 6, v57
v_mad_i32_i24 v76, v76, s25, v60
v_mad_i32_i24 v77, v77, s25, v61
v_mad_i32_i24 v78, v78, s25, v62
v_mad_i32_i24 v79, v79, s25, v63
v_bfe_u32 v61, v77, 5, 1
v_bfe_u32 v63, v79, 5, 1
v_lshl_add_u32 v77, v61, 3, v77
v_lshl_add_u32 v79, v63, 3, v79
s_waitcnt vmcnt(0)
v_lshl_or_b32 v76, v64, 7, v76
v_lshl_or_b32 v77, v65, 7, v77
v_lshl_or_b32 v78, v66, 7, v78
v_lshl_or_b32 v79, v67, 7, v79
s_waitcnt lgkmcnt(0)
v_cmp_lt_u32 s[46:47], 14, v72
v_cmp_lt_u32 s[48:49], 14, v73
v_cmp_lt_u32 s[50:51], 14, v74
v_cmp_lt_u32 s[52:53], 14, v75
v_lshl_add_u32 v80, v72, 2, v80
v_lshl_add_u32 v81, v73, 2, v81
v_lshl_add_u32 v82, v74, 2, v82
v_lshl_add_u32 v83, v75, 2, v83
s_not_b64 exec, s[46:47]
ds_write_b32 v80, v76
s_not_b64 exec, s[48:49]
ds_write_b32 v81, v77
s_not_b64 exec, s[50:51]
ds_write_b32 v82, v78
s_not_b64 exec, s[52:53]
ds_write_b32 v83, v79
s_mov_b64 exec, -1
s_or_b64 s[38:39], s[46:47], s[48:49]
s_or_b64 s[40:41], s[50:51], s[52:53]
s_or_b64 s[38:39], s[38:39], s[40:41]
G_pb:
s_waitcnt lgkmcnt(0)
s_barrier
global_load_dwordx2 v[98:99], v6, s[18:19] sc1
s_cmp_ge_u32 s17, 4
s_cbranch_scc1 G_noalloc
ds_read_b32 v84, v59
v_add_u32 v86, 112444, v33
v_lshl_add_u32 v86, v33, 1, v86
v_add_u32 v86, v33, v86
s_waitcnt lgkmcnt(0)
v_cmp_lt_u32 vcc, 15, v84
v_subrev_u32 v84, 12, v84
v_lshrrev_b32 v84, 2, v84
s_and_saveexec_b64 s[40:41], vcc
ds_add_rtn_u32 v85, v58, v84 offset:1024
s_waitcnt lgkmcnt(0)
v_lshl_or_b32 v84, v84, 10, v85
ds_write_b32 v59, v85
ds_write_b32 v86, v84
s_mov_b64 exec, -1
s_waitcnt lgkmcnt(0)
G_noalloc:
s_barrier
s_cmp_ge_u32 s17, 10
s_cbranch_scc1 G_pd
s_cmp_eq_u64 s[38:39], 0
s_cbranch_scc1 G_pd
v_mov_b32 v57, 128708
ds_read_b32 v80, v68
ds_read_b32 v81, v69
ds_read_b32 v82, v70
ds_read_b32 v83, v71
v_lshl_add_u32 v72, v72, 2, v57
v_lshl_add_u32 v73, v73, 2, v57
v_lshl_add_u32 v74, v74, 2, v57
v_lshl_add_u32 v75, v75, 2, v57
s_waitcnt lgkmcnt(0)
v_lshl_add_u32 v80, v80, 4, v72
v_lshl_add_u32 v81, v81, 4, v73
v_lshl_add_u32 v82, v82, 4, v74
v_lshl_add_u32 v83, v83, 4, v75
s_mov_b64 exec, s[46:47]
ds_write_b32 v80, v76
s_mov_b64 exec, s[48:49]
ds_write_b32 v81, v77
s_mov_b64 exec, s[50:51]
ds_write_b32 v82, v78
s_mov_b64 exec, s[52:53]
ds_write_b32 v83, v79
s_mov_b64 exec, -1
s_waitcnt lgkmcnt(0)
G_pd:
s_barrier
s_cmp_ge_u32 s17, 10
s_cbranch_scc1 G_nost
ds_read_b128 v[84:87], v36
ds_read_b128 v[88:91], v36 offset:10240
ds_read_b32 v80, v58 offset:1024
s_mov_b32 s35, 0x200000
G_tap:
s_waitcnt vmcnt(0)
v_readfirstlane_b32 s56, v98
v_readfirstlane_b32 s57, v99
s_cmp_lg_u32 s56, 0
s_cbranch_scc1 G_tad
global_load_dwordx2 v[98:99], v6, s[18:19] sc1
s_sub_u32 s35, s35, 1
s_cmp_lg_u32 s35, 0
s_cbranch_scc1 G_tap
G_tad:
s_lshl_b64 s[58:59], s[56:57], 20
s_and_b32 s59, s59, 0xffe00000
s_lshl_b64 s[34:35], s[56:57], 31
s_and_b32 s58, s35, 0xffe00000
s_lshl_b32 s57, s56, 10
s_and_b32 s57, s57, 0xffe00000
s_lshl_b32 s56, s56, 21
s_waitcnt lgkmcnt(2)
v_or_b32 v84, s56, v84
v_or_b32 v85, s57, v85
v_or_b32 v86, s58, v86
v_or_b32 v87, s59, v87
buffer_store_dwordx4 v[84:87], v33, s[8:11], s27 offen sc1
s_waitcnt lgkmcnt(0)
v_or_b32 v88, s56, v88
v_or_b32 v89, s57, v89
v_or_b32 v90, s58, v90
v_or_b32 v91, s59, v91
v_readfirstlane_b32 s34, v80
s_add_u32 s35, s27, 10240
s_movk_i32 s36, 360
v_cmp_gt_u32 vcc, s36, v0
s_cmp_ge_u32 s17, 6
s_cbranch_scc1 G_st2
s_and_saveexec_b64 s[40:41], vcc
buffer_store_dwordx4 v[88:91], v33, s[8:11], s35 offen sc1
s_mov_b64 exec, -1
G_st2:
s_add_u32 s34, s34, 7
s_and_b32 s34, s34, -8
s_lshl_b32 s36, s17, 6
s_add_u32 s35, s27, 16000
v_mov_b32 v81, v0
v_add_u32 v82, 16384, v36
G_ovst:
s_cmp_ge_u32 s36, s34
s_cbranch_scc1 G_stdone
v_cmp_gt_u32 vcc, s34, v81
ds_read_b128 v[92:95], v82
s_waitcnt lgkmcnt(0)
v_or_b32 v92, s56, v92
v_or_b32 v93, s57, v93
v_or_b32 v94, s58, v94
v_or_b32 v95, s59, v95
s_and_saveexec_b64 s[40:41], vcc
buffer_store_dwordx4 v[92:95], v33, s[8:11], s35 offen sc1
s_mov_b64 exec, -1
s_add_u32 s36, s36, 640
s_add_u32 s35, s35, 10240
v_add_u32 v81, 640, v81
v_add_u32 v82, 10240, v82
s_branch G_ovst
G_nost:
s_mov_b32 s35, 0x200000
G_tbp:
s_waitcnt vmcnt(0)
v_readfirstlane_b32 s56, v98
v_readfirstlane_b32 s57, v99
s_cmp_lg_u32 s56, 0
s_cbranch_scc1 G_tbd
global_load_dwordx2 v[98:99], v6, s[18:19] sc1
s_sub_u32 s35, s35, 1
s_cmp_lg_u32 s35, 0
s_cbranch_scc1 G_tbp
G_tbd:
s_lshl_b64 s[58:59], s[56:57], 20
s_and_b32 s59, s59, 0xffe00000
s_lshl_b64 s[34:35], s[56:57], 31
s_and_b32 s58, s35, 0xffe00000
s_lshl_b32 s57, s56, 10
s_and_b32 s57, s57, 0xffe00000
s_lshl_b32 s56, s56, 21
G_stdone:
s_setprio 0
s_barrier
v_lshrrev_b32 v36, 2, v0
v_mul_u32_u24 v36, 28416, v36
v_and_b32 v37, 3, v0
v_lshl_add_u32 v33, v37, 4, v36
s_lshl_b32 s3, s16, 6
v_mov_b32 v38, 0x40000000
s_lshr_b32 s36, s17, 2
s_and_b32 s37, s17, 3
v_and_b32 v51, 15, v17
s_cmp_ge_u32 s17, 12
s_cbranch_scc1 G_noq
v_lshrrev_b32 v52, 2, v51
v_lshl_add_u32 v52, v49, 3, v52
v_lshlrev_b32 v52, 7, v52
v_and_b32 v53, 3, v17
v_lshl_add_u32 v52, v53, 3, v52
s_lshl_b32 s35, s37, 5
v_add_u32 v52, s35, v52
ds_read_b64_tr_b16 v[76:77], v52 offset:24576
ds_read_b64_tr_b16 v[78:79], v52 offset:25088
ds_read_b64_tr_b16 v[80:81], v52 offset:28672
ds_read_b64_tr_b16 v[82:83], v52 offset:29184
v_and_b32 v53, 6, v51
v_xor_b32 v53, v49, v53
v_lshlrev_b32 v53, 4, v53
s_cmp_eq_u32 s36, 2
s_cselect_b32 s35, 7, 15
v_and_b32 v54, s35, v51
v_lshl_add_u32 v53, v54, 7, v53
s_lshl_b32 s35, s36, 11
v_add_u32 v53, s35, v53
v_xor_b32 v54, 64, v53
ds_read_b128 v[68:71], v53 offset:32768
ds_read_b128 v[72:75], v54 offset:32768
s_lshl_b32 s35, s37, 1
v_lshrrev_b32 v52, 1, v49
v_or_b32 v52, s35, v52
v_xor_b32 v52, s36, v52
v_xor_b32 v52, v51, v52
v_lshlrev_b32 v52, 4, v52
v_lshl_add_u32 v52, v51, 9, v52
v_and_b32 v53, 1, v49
v_lshl_add_u32 v52, v53, 3, v52
s_lshl_b32 s35, s36, 13
v_add_u32 v52, s35, v52
v_xor_b32 v53, 0x80, v52
s_waitcnt lgkmcnt(1)
v_mfma_f32_16x16x32_bf16 v[100:103], v[76:79], v[68:71], 0
s_waitcnt lgkmcnt(0)
v_mfma_f32_16x16x32_bf16 v[100:103], v[80:83], v[72:75], v[100:103]
G_noq:
v_lshlrev_b32 v54, 4, v48
v_or_b32 v0, s17, v54
v_and_b32 v55, 1, v49
v_lshl_add_u32 v55, v55, 3, v48
v_xor_b32 v55, s17, v55
v_lshlrev_b32 v1, 4, v55
v_and_b32 v50, 0x380, v34
v_lshlrev_b32 v55, 1, v17
v_and_or_b32 v50, v55, 48, v50
v_lshrrev_b32 v55, 2, v48
v_mul_u32_u24 v55, 1088, v55
v_and_b32 v56, 3, v17
v_lshl_add_u32 v50, v56, 2, v50
v_add3_u32 v2, v50, v55, s26
s_mul_i32 s34, s17, 1280
s_add_u32 s34, s34, 84480
v_lshrrev_b32 v50, 3, v17
v_lshlrev_b32 v50, 2, v50
v_add_u32 v4, s34, v50
v_lshl_add_u32 v5, v48, 5, v4
s_cmp_ge_u32 s17, 12
s_cbranch_scc1 G_noq2
v_cvt_pk_bf16_f32 v96, v100, v101
v_cvt_pk_bf16_f32 v97, v102, v103
ds_write_b64 v52, v[96:97] offset:0
ds_write_b64 v53, v[96:97] offset:0
G_noq2:
v_and_b32 v50, 2, v49
v_xor_b32 v50, v56, v50
v_and_b32 v55, 1, v49
v_lshl_add_u32 v50, v55, 2, v50
s_and_b32 s34, s17, 6
v_xor_b32 v50, s34, v50
v_lshlrev_b32 v50, 4, v50
v_lshl_add_u32 v50, v56, 11, v50
v_and_b32 v55, 4, v17
v_lshl_add_u32 v50, v55, 1, v50
s_lshl_b32 s34, s17, 7
s_add_u32 s34, s34, 104960
v_add_u32 v104, s34, v50
s_mul_i32 s34, s17, 2432
s_add_u32 s34, s34, 111104
v_lshrrev_b32 v50, 3, v17
v_mul_u32_u24 v50, 144, v50
v_add3_u32 v107, v50, v54, s34
v_lshrrev_b32 v55, 2, v48
v_mul_u32_u24 v55, 1216, v55
v_add3_u32 v50, v50, v55, s34
v_lshl_add_u32 v108, v56, 2, v50
v_mov_b32 v105, 0
v_mov_b32 v106, 0
s_sub_u32 s36, s17, 8
s_cmp_ge_u32 s36, 6
s_cbranch_scc1 G_nofr
s_and_b32 s37, s36, 1
s_lshr_b32 s36, s36, 1
v_lshrrev_b32 v50, 2, v51
v_lshl_add_u32 v50, v49, 2, v50
v_lshlrev_b32 v50, 8, v50
v_lshl_add_u32 v50, v56, 4, v50
s_lshl_b32 s35, s37, 6
s_add_u32 s34, s35, 40960
v_add_u32 v50, s34, v50
ds_read_b64_tr_b16 v[88:89], v50 offset:0
ds_read_b64_tr_b16 v[90:91], v50 offset:128
ds_read_b64_tr_b16 v[92:93], v50 offset:4096
ds_read_b64_tr_b16 v[94:95], v50 offset:4224
ds_read_b64_tr_b16 v[96:97], v50 offset:8
ds_read_b64_tr_b16 v[98:99], v50 offset:136
ds_read_b64_tr_b16 v[100:101], v50 offset:4104
ds_read_b64_tr_b16 v[102:103], v50 offset:4232
v_and_b32 v50, 6, v51
v_xor_b32 v50, v49, v50
v_lshlrev_b32 v50, 4, v50
v_lshl_add_u32 v50, v51, 7, v50
s_lshl_b32 s34, s36, 11
v_add_u32 v55, s34, v50
v_add_u32 v105, 104960, v55
v_lshlrev_b32 v50, 7, v51
v_lshl_add_u32 v50, v49, 4, v50
s_add_u32 s34, s34, s35
v_add_u32 v106, s34, v50
G_nofr:
v_mov_b32 v112, 0
v_mov_b32 v113, 0
v_mov_b32 v114, 0
v_mov_b32 v115, 0
v_mov_b32 v116, 0
v_mov_b32 v117, 0
v_mov_b32 v118, 0
v_mov_b32 v119, 0
v_mov_b32 v120, 0
v_mov_b32 v121, 0
v_mov_b32 v122, 0
v_mov_b32 v123, 0
v_mov_b32 v124, 0
v_mov_b32 v125, 0
v_mov_b32 v126, 0
v_mov_b32 v127, 0
v_mov_b32 v24, 0
v_mov_b32 v25, 0
v_mov_b32 v26, 0
v_mov_b32 v27, 0
v_mov_b32 v28, 0
v_mov_b32 v29, 0
v_mov_b32 v30, 0
v_mov_b32 v31, 0
v_mov_b32 v40, 0
v_mov_b32 v41, 0
v_mov_b32 v42, 0
v_mov_b32 v43, 0
v_mov_b32 v44, 0
v_mov_b32 v45, 0
v_mov_b32 v46, 0
v_mov_b32 v47, 0
v_mov_b32 v58, 83968
v_lshl_add_u32 v59, v17, 2, v58

s_setprio 3
s_mov_b64 s[40:41], -1
s_cmp_lg_u32 s17, 15
s_cselect_b32 s41, -1, 0xff
s_mov_b32 s42, 0x200000
s_mov_b32 s34, 0x200000
G_poll:
s_sleep 6
buffer_load_dwordx4 v[60:63], v33, s[8:11], s3 offen sc1
s_waitcnt vmcnt(0)
v_xor_b32 v60, s56, v60
v_xor_b32 v61, s57, v61
v_xor_b32 v62, s58, v62
v_xor_b32 v63, s59, v63
v_or3_b32 v56, v60, v61, v62
v_or_b32 v56, v56, v63
v_cmp_le_u32 vcc, s42, v56
s_nop 1
s_and_b64 vcc, vcc, s[40:41]
s_cbranch_scc0 G_polld
s_mov_b64 exec, vcc
s_sub_u32 s34, s34, 1
s_cmp_lg_u32 s34, 0
s_cbranch_scc1 G_poll
G_polld:
s_mov_b64 exec, -1
s_nop 0
v_mov_b32_dpp v56, v63 quad_perm:[3,3,3,3] row_mask:0xf bank_mask:0xf
v_cmp_ne_u32 vcc, s43, v56
v_lshrrev_b32 v57, 10, v56
v_and_b32 v56, 0x3ff, v56
s_and_b64 vcc, vcc, s[40:41]
v_lshl_add_u32 v56, v56, 4, v33
v_cndmask_b32 v57, 0, v57, vcc
v_cmp_lt_u32 s[38:39], v37, v57
v_cmp_lt_u32 vcc, 4, v57
s_mov_b32 s36, 16000
v_cndmask_b32 v56, v38, v56, s[38:39]
s_cbranch_vccz G_noflag
v_mov_b32 v64, 0xffff
ds_write_b32 v58, v64 offset:64
G_noflag:
s_cmp_eq_u64 s[38:39], 0
s_cbranch_scc1 G_noov
buffer_load_dwordx4 v[64:67], v56, s[8:11], s36 offen sc1
G_noov:
v_cmp_ne_u32 s[46:47], s43, v60
v_cmp_ne_u32 s[48:49], s43, v61
v_cmp_ne_u32 s[50:51], s43, v62
v_cmp_ne_u32 s[52:53], s43, v63
v_and_b32 v80, 15, v60
v_and_b32 v81, 15, v61
v_and_b32 v82, 15, v62
v_and_b32 v83, 15, v63
v_lshl_add_u32 v84, v80, 2, v58
v_lshl_add_u32 v85, v81, 2, v58
v_lshl_add_u32 v86, v82, 2, v58
v_lshl_add_u32 v87, v83, 2, v58
s_and_b32 s52, s52, 0x77777777
s_and_b32 s53, s53, 0x77777777
s_and_b64 s[46:47], s[46:47], s[40:41]
s_mov_b64 exec, s[46:47]
ds_add_rtn_u32 v68, v84, v39
s_and_b64 s[48:49], s[48:49], s[40:41]
s_mov_b64 exec, s[48:49]
ds_add_rtn_u32 v69, v85, v39
s_and_b64 s[50:51], s[50:51], s[40:41]
s_mov_b64 exec, s[50:51]
ds_add_rtn_u32 v70, v86, v39
s_and_b64 s[52:53], s[52:53], s[40:41]
s_mov_b64 exec, s[52:53]
ds_add_rtn_u32 v71, v87, v39
s_mov_b64 exec, -1
v_mad_u32_u24 v80, v80, s29, v58
v_mad_u32_u24 v81, v81, s29, v58
v_mad_u32_u24 v82, v82, s29, v58
v_mad_u32_u24 v83, v83, s29, v58
s_waitcnt lgkmcnt(3)
v_lshl_add_u32 v80, v68, 2, v80
s_mov_b64 exec, s[46:47]
ds_write_b32 v80, v60 offset:512
s_mov_b64 exec, -1
s_waitcnt lgkmcnt(3)
v_lshl_add_u32 v81, v69, 2, v81
s_mov_b64 exec, s[48:49]
ds_write_b32 v81, v61 offset:512
s_mov_b64 exec, -1
s_waitcnt lgkmcnt(3)
v_lshl_add_u32 v82, v70, 2, v82
s_mov_b64 exec, s[50:51]
ds_write_b32 v82, v62 offset:512
s_mov_b64 exec, -1
s_waitcnt lgkmcnt(3)
v_lshl_add_u32 v83, v71, 2, v83
s_mov_b64 exec, s[52:53]
ds_write_b32 v83, v63 offset:512
s_mov_b64 exec, -1
s_cmp_eq_u64 s[38:39], 0
s_cbranch_scc1 G_ins2
s_mov_b32 s34, 0x200000
G_poll2:
s_waitcnt vmcnt(0)
v_xor_b32 v64, s56, v64
v_xor_b32 v65, s57, v65
v_xor_b32 v66, s58, v66
v_xor_b32 v67, s59, v67
v_or3_b32 v57, v64, v65, v66
v_or_b32 v57, v57, v67
v_cmp_le_u32 vcc, s42, v57
s_nop 1
s_and_b64 vcc, vcc, s[38:39]
s_cbranch_scc0 G_poll2d
buffer_load_dwordx4 v[64:67], v56, s[8:11], s36 offen sc1
s_sub_u32 s34, s34, 1
s_cmp_lg_u32 s34, 0
s_cbranch_scc1 G_poll2
G_poll2d:
v_cmp_ne_u32 s[46:47], s43, v64
v_cmp_ne_u32 s[48:49], s43, v65
v_cmp_ne_u32 s[50:51], s43, v66
v_cmp_ne_u32 s[52:53], s43, v67
v_and_b32 v80, 15, v64
v_and_b32 v81, 15, v65
v_and_b32 v82, 15, v66
v_and_b32 v83, 15, v67
v_lshl_add_u32 v84, v80, 2, v58
v_lshl_add_u32 v85, v81, 2, v58
v_lshl_add_u32 v86, v82, 2, v58
v_lshl_add_u32 v87, v83, 2, v58
s_and_b64 s[46:47], s[46:47], s[38:39]
s_mov_b64 exec, s[46:47]
ds_add_rtn_u32 v68, v84, v39
s_and_b64 s[48:49], s[48:49], s[38:39]
s_mov_b64 exec, s[48:49]
ds_add_rtn_u32 v69, v85, v39
s_and_b64 s[50:51], s[50:51], s[38:39]
s_mov_b64 exec, s[50:51]
ds_add_rtn_u32 v70, v86, v39
s_and_b64 s[52:53], s[52:53], s[38:39]
s_mov_b64 exec, s[52:53]
ds_add_rtn_u32 v71, v87, v39
s_mov_b64 exec, -1
v_mad_u32_u24 v80, v80, s29, v58
v_mad_u32_u24 v81, v81, s29, v58
v_mad_u32_u24 v82, v82, s29, v58
v_mad_u32_u24 v83, v83, s29, v58
s_waitcnt lgkmcnt(3)
v_lshl_add_u32 v80, v68, 2, v80
s_mov_b64 exec, s[46:47]
ds_write_b32 v80, v64 offset:512
s_mov_b64 exec, -1
s_waitcnt lgkmcnt(3)
v_lshl_add_u32 v81, v69, 2, v81
s_mov_b64 exec, s[48:49]
ds_write_b32 v81, v65 offset:512
s_mov_b64 exec, -1
s_waitcnt lgkmcnt(3)
v_lshl_add_u32 v82, v70, 2, v82
s_mov_b64 exec, s[50:51]
ds_write_b32 v82, v66 offset:512
s_mov_b64 exec, -1
s_waitcnt lgkmcnt(3)
v_lshl_add_u32 v83, v71, 2, v83
s_mov_b64 exec, s[52:53]
ds_write_b32 v83, v67 offset:512
s_mov_b64 exec, -1
G_ins2:
G_inserted:
s_movk_i32 s35, 320
s_mov_b32 s30, 0xcccccccc
s_mov_b32 s31, 0xcccccccc
s_mov_b32 s32, 0xaaaaaaaa
s_mov_b32 s33, 0xaaaaaaaa
s_mov_b32 s27, 0
v_add_u32 v4, 0x200, v4
v_add_u32 v5, 0x200, v5
s_waitcnt lgkmcnt(0)
s_barrier
G_round:
ds_read_b32 v48, v59
ds_read2_b32 v[8:9], v4 offset0:0 offset1:8
ds_read2_b32 v[10:11], v4 offset0:16 offset1:24
ds_read2_b32 v[12:13], v4 offset0:32 offset1:40
ds_read2_b32 v[14:15], v4 offset0:48 offset1:56
ds_read_b32 v7, v5
s_waitcnt lgkmcnt(5)
v_cmp_lt_u32 vcc, s35, v48
v_readlane_b32 s21, v48, s17
s_cmp_lg_u32 s23, 0
s_cbranch_scc1 G_go
s_and_b32 s34, vcc_lo, 0x1ffff
s_cbranch_scc1 G_slow
G_go:
s_add_u32 s20, s21, 63
s_lshr_b32 s21, s20, 6
s_max_u32 s21, s21, 1
s_sub_u32 s21, s21, 1
s_lshl_b32 s34, s21, 6
s_sub_i32 s20, s20, 63
s_sub_i32 s20, s20, s34
s_cmp_eq_u32 s21, 2
s_cbranch_scc1 G_hit
s_lshl_b32 s34, s21, 8
s_sub_u32 s34, s34, 0x200
v_add_u32 v4, s34, v4
v_add_u32 v5, s34, v5
ds_read2_b32 v[8:9], v4 offset0:0 offset1:8
ds_read2_b32 v[10:11], v4 offset0:16 offset1:24
ds_read2_b32 v[12:13], v4 offset0:32 offset1:40
ds_read2_b32 v[14:15], v4 offset0:48 offset1:56
ds_read_b32 v7, v5
G_hit:
s_setprio 3
s_waitcnt lgkmcnt(1)
v_xor_b32 v16, v8, v0
buffer_load_dwordx4 v[16:19], v16, s[4:7], 0 offen
v_xor_b32 v20, v9, v0
buffer_load_dwordx4 v[20:23], v20, s[4:7], 0 offen
s_cmp_le_i32 s20, 16
s_cbranch_scc1 G_xd0
v_xor_b32 v24, v10, v0
buffer_load_dwordx4 v[24:27], v24, s[4:7], 0 offen
v_xor_b32 v28, v11, v0
buffer_load_dwordx4 v[28:31], v28, s[4:7], 0 offen
s_cmp_le_i32 s20, 32
s_cbranch_scc1 G_xd0
v_xor_b32 v32, v12, v0
buffer_load_dwordx4 v[32:35], v32, s[4:7], 0 offen
v_xor_b32 v36, v13, v0
buffer_load_dwordx4 v[36:39], v36, s[4:7], 0 offen
s_cmp_le_i32 s20, 48
s_cbranch_scc1 G_xd0
v_xor_b32 v40, v14, v0
buffer_load_dwordx4 v[40:43], v40, s[4:7], 0 offen
v_xor_b32 v44, v15, v0
buffer_load_dwordx4 v[44:47], v44, s[4:7], 0 offen
G_xd0:
v_mad_legacy_u16 v8, v8, s24, v1
v_mad_legacy_u16 v9, v9, s24, v1
v_mad_legacy_u16 v10, v10, s24, v1
v_mad_legacy_u16 v11, v11, s24, v1
v_mad_legacy_u16 v12, v12, s24, v1
v_mad_legacy_u16 v13, v13, s24, v1
v_mad_legacy_u16 v14, v14, s24, v1
v_mad_legacy_u16 v15, v15, s24, v1
s_setprio 2
G_disp:
s_cmp_gt_i32 s20, 32
s_cbranch_scc1 G_b0
ds_read_b128 v[48:51], v8 offset:0
ds_read_b128 v[52:55], v9 offset:0
ds_read_b128 v[56:59], v10 offset:0
ds_read_b128 v[60:63], v11 offset:0
v_subrev_u32 v4, 0x100, v4
v_subrev_u32 v5, 0x100, v5
ds_read2_b32 v[8:9], v4 offset0:0 offset1:8
ds_read2_b32 v[10:11], v4 offset0:16 offset1:24
ds_read2_b32 v[12:13], v4 offset0:32 offset1:40
ds_read2_b32 v[14:15], v4 offset0:48 offset1:56
s_sub_i32 s21, s21, 1
s_waitcnt vmcnt(0) lgkmcnt(4)
v_dot2_f32_bf16 v80, v16, v48, 0
v_dot2_f32_bf16 v81, v20, v52, 0
v_dot2_f32_bf16 v82, v24, v56, 0
v_dot2_f32_bf16 v83, v28, v60, 0
v_dot2_f32_bf16 v80, v17, v49, v80
v_dot2_f32_bf16 v81, v21, v53, v81
v_dot2_f32_bf16 v82, v25, v57, v82
v_dot2_f32_bf16 v83, v29, v61, v83
v_dot2_f32_bf16 v80, v18, v50, v80
v_dot2_f32_bf16 v81, v22, v54, v81
v_dot2_f32_bf16 v82, v26, v58, v82
v_dot2_f32_bf16 v83, v30, v62, v83
v_dot2_f32_bf16 v80, v19, v51, v80
v_dot2_f32_bf16 v81, v23, v55, v81
v_dot2_f32_bf16 v82, v27, v59, v82
v_dot2_f32_bf16 v83, v31, v63, v83
v_pk_mov_b32 v[48:49], v[16:17], v[20:21] op_sel:[0,0]
v_pk_mov_b32 v[50:51], v[24:25], v[28:29] op_sel:[0,0]
v_pk_mov_b32 v[52:53], v[16:17], v[20:21] op_sel:[1,1]
v_pk_mov_b32 v[54:55], v[24:25], v[28:29] op_sel:[1,1]
v_pk_mov_b32 v[56:57], v[18:19], v[22:23] op_sel:[0,0]
v_pk_mov_b32 v[58:59], v[26:27], v[30:31] op_sel:[0,0]
v_pk_mov_b32 v[60:61], v[18:19], v[22:23] op_sel:[1,1]
v_pk_mov_b32 v[62:63], v[26:27], v[30:31] op_sel:[1,1]
v_add_f32_dpp v80, v80, v80 row_half_mirror row_mask:0xf bank_mask:0x5
v_add_f32_dpp v81, v81, v81 row_half_mirror row_mask:0xf bank_mask:0x5
v_add_f32_dpp v82, v82, v82 row_half_mirror row_mask:0xf bank_mask:0x5
v_add_f32_dpp v83, v83, v83 row_half_mirror row_mask:0xf bank_mask:0x5
v_bitop3_b32 v7, v7, 48, v2 bitop3:0x6a
v_add_f32_dpp v84, v80, v80 quad_perm:[2,3,0,1] row_mask:0xf bank_mask:0xf
v_add_f32_dpp v85, v81, v81 quad_perm:[2,3,0,1] row_mask:0xf bank_mask:0xf
v_add_f32_dpp v86, v82, v82 quad_perm:[2,3,0,1] row_mask:0xf bank_mask:0xf
v_add_f32_dpp v87, v83, v83 quad_perm:[2,3,0,1] row_mask:0xf bank_mask:0xf
v_cndmask_b32 v80, v84, v86, s[30:31]
v_cndmask_b32 v81, v85, v87, s[30:31]
s_nop 0
v_add_f32_dpp v82, v80, v80 quad_perm:[1,0,3,2] row_mask:0xf bank_mask:0xf
v_add_f32_dpp v83, v81, v81 quad_perm:[1,0,3,2] row_mask:0xf bank_mask:0xf
v_cndmask_b32 v84, v82, v83, s[32:33]
v_mul_f32 v84, s28, v84
v_exp_f32 v84, v84
s_nop 0
v_add_f32 v84, 1.0, v84
v_rcp_f32 v84, v84
s_nop 0
v_cvt_pk_bf16_f32 v85, v84, 0
v_cvt_pk_bf16_f32 v84, 0, v84
ds_write2_b32 v7, v85, v84 offset0:0 offset1:16
ds_read_b128 v[16:19], v3
ds_write2_b32 v7, v6, v6 offset0:0 offset1:16
ds_read_b32 v7, v5
s_waitcnt lgkmcnt(2)
v_mfma_f32_16x16x32_bf16 v[112:115], v[48:51], v[16:19], v[112:115]
v_mfma_f32_16x16x32_bf16 v[116:119], v[52:55], v[16:19], v[116:119]
v_mfma_f32_16x16x32_bf16 v[120:123], v[56:59], v[16:19], v[120:123]
v_mfma_f32_16x16x32_bf16 v[124:127], v[60:63], v[16:19], v[124:127]
s_cmp_lt_i32 s21, 0
s_cbranch_scc1 G_nonexth
v_xor_b32 v16, v8, v0
v_xor_b32 v20, v9, v0
v_xor_b32 v24, v10, v0
v_xor_b32 v28, v11, v0
v_xor_b32 v32, v12, v0
v_xor_b32 v36, v13, v0
v_xor_b32 v40, v14, v0
v_xor_b32 v44, v15, v0
buffer_load_dwordx4 v[16:19], v16, s[4:7], 0 offen
buffer_load_dwordx4 v[20:23], v20, s[4:7], 0 offen
buffer_load_dwordx4 v[24:27], v24, s[4:7], 0 offen
buffer_load_dwordx4 v[28:31], v28, s[4:7], 0 offen
buffer_load_dwordx4 v[32:35], v32, s[4:7], 0 offen
buffer_load_dwordx4 v[36:39], v36, s[4:7], 0 offen
buffer_load_dwordx4 v[40:43], v40, s[4:7], 0 offen
buffer_load_dwordx4 v[44:47], v44, s[4:7], 0 offen
v_mad_legacy_u16 v8, v8, s24, v1
v_mad_legacy_u16 v9, v9, s24, v1
v_mad_legacy_u16 v10, v10, s24, v1
v_mad_legacy_u16 v11, v11, s24, v1
v_mad_legacy_u16 v12, v12, s24, v1
v_mad_legacy_u16 v13, v13, s24, v1
v_mad_legacy_u16 v14, v14, s24, v1
v_mad_legacy_u16 v15, v15, s24, v1
G_nonexth:
s_branch G_b1x
G_b0:
ds_read_b128 v[48:51], v8 offset:0
ds_read_b128 v[52:55], v9 offset:0
ds_read_b128 v[56:59], v10 offset:0
ds_read_b128 v[60:63], v11 offset:0
ds_read_b128 v[64:67], v12 offset:0
ds_read_b128 v[68:71], v13 offset:0
ds_read_b128 v[72:75], v14 offset:0
ds_read_b128 v[76:79], v15 offset:0
v_subrev_u32 v4, 0x100, v4
v_subrev_u32 v5, 0x100, v5
ds_read2_b32 v[8:9], v4 offset0:0 offset1:8
ds_read2_b32 v[10:11], v4 offset0:16 offset1:24
ds_read2_b32 v[12:13], v4 offset0:32 offset1:40
ds_read2_b32 v[14:15], v4 offset0:48 offset1:56
s_sub_i32 s21, s21, 1
s_waitcnt vmcnt(0) lgkmcnt(8)
v_dot2_f32_bf16 v80, v16, v48, 0
v_dot2_f32_bf16 v81, v20, v52, 0
v_dot2_f32_bf16 v82, v24, v56, 0
v_dot2_f32_bf16 v83, v28, v60, 0
v_dot2_f32_bf16 v80, v17, v49, v80
v_dot2_f32_bf16 v81, v21, v53, v81
v_dot2_f32_bf16 v82, v25, v57, v82
v_dot2_f32_bf16 v83, v29, v61, v83
v_dot2_f32_bf16 v80, v18, v50, v80
v_dot2_f32_bf16 v81, v22, v54, v81
v_dot2_f32_bf16 v82, v26, v58, v82
v_dot2_f32_bf16 v83, v30, v62, v83
v_dot2_f32_bf16 v80, v19, v51, v80
v_dot2_f32_bf16 v81, v23, v55, v81
v_dot2_f32_bf16 v82, v27, v59, v82
v_dot2_f32_bf16 v83, v31, v63, v83
s_waitcnt vmcnt(0) lgkmcnt(4)
v_dot2_f32_bf16 v84, v32, v64, 0
v_dot2_f32_bf16 v85, v36, v68, 0
v_dot2_f32_bf16 v86, v40, v72, 0
v_dot2_f32_bf16 v87, v44, v76, 0
v_dot2_f32_bf16 v84, v33, v65, v84
v_dot2_f32_bf16 v85, v37, v69, v85
v_dot2_f32_bf16 v86, v41, v73, v86
v_dot2_f32_bf16 v87, v45, v77, v87
v_dot2_f32_bf16 v84, v34, v66, v84
v_dot2_f32_bf16 v85, v38, v70, v85
v_dot2_f32_bf16 v86, v42, v74, v86
v_dot2_f32_bf16 v87, v46, v78, v87
v_dot2_f32_bf16 v84, v35, v67, v84
v_dot2_f32_bf16 v85, v39, v71, v85
v_dot2_f32_bf16 v86, v43, v75, v86
v_dot2_f32_bf16 v87, v47, v79, v87
v_pk_mov_b32 v[48:49], v[16:17], v[20:21] op_sel:[0,0]
v_pk_mov_b32 v[50:51], v[24:25], v[28:29] op_sel:[0,0]
v_pk_mov_b32 v[52:53], v[16:17], v[20:21] op_sel:[1,1]
v_pk_mov_b32 v[54:55], v[24:25], v[28:29] op_sel:[1,1]
v_pk_mov_b32 v[56:57], v[18:19], v[22:23] op_sel:[0,0]
v_pk_mov_b32 v[58:59], v[26:27], v[30:31] op_sel:[0,0]
v_pk_mov_b32 v[60:61], v[18:19], v[22:23] op_sel:[1,1]
v_pk_mov_b32 v[62:63], v[26:27], v[30:31] op_sel:[1,1]
v_pk_mov_b32 v[64:65], v[32:33], v[36:37] op_sel:[0,0]
v_pk_mov_b32 v[66:67], v[40:41], v[44:45] op_sel:[0,0]
v_pk_mov_b32 v[68:69], v[32:33], v[36:37] op_sel:[1,1]
v_pk_mov_b32 v[70:71], v[40:41], v[44:45] op_sel:[1,1]
v_pk_mov_b32 v[72:73], v[34:35], v[38:39] op_sel:[0,0]
v_pk_mov_b32 v[74:75], v[42:43], v[46:47] op_sel:[0,0]
v_pk_mov_b32 v[76:77], v[34:35], v[38:39] op_sel:[1,1]
v_pk_mov_b32 v[78:79], v[42:43], v[46:47] op_sel:[1,1]
v_add_f32_dpp v80, v80, v80 row_half_mirror row_mask:0xf bank_mask:0x5
v_add_f32_dpp v81, v81, v81 row_half_mirror row_mask:0xf bank_mask:0x5
v_add_f32_dpp v82, v82, v82 row_half_mirror row_mask:0xf bank_mask:0x5
v_add_f32_dpp v83, v83, v83 row_half_mirror row_mask:0xf bank_mask:0x5
v_add_f32_dpp v80, v84, v84 row_half_mirror row_mask:0xf bank_mask:0xa
v_add_f32_dpp v81, v85, v85 row_half_mirror row_mask:0xf bank_mask:0xa
v_add_f32_dpp v82, v86, v86 row_half_mirror row_mask:0xf bank_mask:0xa
v_add_f32_dpp v83, v87, v87 row_half_mirror row_mask:0xf bank_mask:0xa
v_bitop3_b32 v7, v7, 48, v2 bitop3:0x6a
v_add_f32_dpp v84, v80, v80 quad_perm:[2,3,0,1] row_mask:0xf bank_mask:0xf
v_add_f32_dpp v85, v81, v81 quad_perm:[2,3,0,1] row_mask:0xf bank_mask:0xf
v_add_f32_dpp v86, v82, v82 quad_perm:[2,3,0,1] row_mask:0xf bank_mask:0xf
v_add_f32_dpp v87, v83, v83 quad_perm:[2,3,0,1] row_mask:0xf bank_mask:0xf
v_cndmask_b32 v80, v84, v86, s[30:31]
v_cndmask_b32 v81, v85, v87, s[30:31]
s_nop 0
v_add_f32_dpp v82, v80, v80 quad_perm:[1,0,3,2] row_mask:0xf bank_mask:0xf
v_add_f32_dpp v83, v81, v81 quad_perm:[1,0,3,2] row_mask:0xf bank_mask:0xf
v_cndmask_b32 v84, v82, v83, s[32:33]
v_mul_f32 v84, s28, v84
v_exp_f32 v84, v84
s_nop 0
v_add_f32 v84, 1.0, v84
v_rcp_f32 v84, v84
s_nop 0
v_cvt_pk_bf16_f32 v85, v84, 0
v_cvt_pk_bf16_f32 v84, 0, v84
ds_write2_b32 v7, v85, v84 offset0:0 offset1:16
ds_read_b128 v[16:19], v3
ds_read_b128 v[20:23], v3 offset:1088
ds_write2_b32 v7, v6, v6 offset0:0 offset1:16
ds_read_b32 v7, v5
s_waitcnt lgkmcnt(3)
v_mfma_f32_16x16x32_bf16 v[112:115], v[48:51], v[16:19], v[112:115]
v_mfma_f32_16x16x32_bf16 v[116:119], v[52:55], v[16:19], v[116:119]
v_mfma_f32_16x16x32_bf16 v[120:123], v[56:59], v[16:19], v[120:123]
v_mfma_f32_16x16x32_bf16 v[124:127], v[60:63], v[16:19], v[124:127]
s_waitcnt lgkmcnt(2)
v_mfma_f32_16x16x32_bf16 v[112:115], v[64:67], v[20:23], v[112:115]
v_mfma_f32_16x16x32_bf16 v[116:119], v[68:71], v[20:23], v[116:119]
v_mfma_f32_16x16x32_bf16 v[120:123], v[72:75], v[20:23], v[120:123]
v_mfma_f32_16x16x32_bf16 v[124:127], v[76:79], v[20:23], v[124:127]
s_cmp_lt_i32 s21, 0
s_cbranch_scc1 G_nonextb
v_xor_b32 v16, v8, v0
v_xor_b32 v20, v9, v0
v_xor_b32 v24, v10, v0
v_xor_b32 v28, v11, v0
v_xor_b32 v32, v12, v0
v_xor_b32 v36, v13, v0
v_xor_b32 v40, v14, v0
v_xor_b32 v44, v15, v0
buffer_load_dwordx4 v[16:19], v16, s[4:7], 0 offen
buffer_load_dwordx4 v[20:23], v20, s[4:7], 0 offen
buffer_load_dwordx4 v[24:27], v24, s[4:7], 0 offen
buffer_load_dwordx4 v[28:31], v28, s[4:7], 0 offen
buffer_load_dwordx4 v[32:35], v32, s[4:7], 0 offen
buffer_load_dwordx4 v[36:39], v36, s[4:7], 0 offen
buffer_load_dwordx4 v[40:43], v40, s[4:7], 0 offen
buffer_load_dwordx4 v[44:47], v44, s[4:7], 0 offen
v_mad_legacy_u16 v8, v8, s24, v1
v_mad_legacy_u16 v9, v9, s24, v1
v_mad_legacy_u16 v10, v10, s24, v1
v_mad_legacy_u16 v11, v11, s24, v1
v_mad_legacy_u16 v12, v12, s24, v1
v_mad_legacy_u16 v13, v13, s24, v1
v_mad_legacy_u16 v14, v14, s24, v1
v_mad_legacy_u16 v15, v15, s24, v1
G_nonextb:
G_b1x:
s_cmp_lt_i32 s21, 0
s_cbranch_scc1 G_done
ds_read_b128 v[48:51], v8 offset:0
ds_read_b128 v[52:55], v9 offset:0
ds_read_b128 v[56:59], v10 offset:0
ds_read_b128 v[60:63], v11 offset:0
ds_read_b128 v[64:67], v12 offset:0
ds_read_b128 v[68:71], v13 offset:0
ds_read_b128 v[72:75], v14 offset:0
ds_read_b128 v[76:79], v15 offset:0
v_subrev_u32 v4, 0x100, v4
v_subrev_u32 v5, 0x100, v5
ds_read2_b32 v[8:9], v4 offset0:0 offset1:8
ds_read2_b32 v[10:11], v4 offset0:16 offset1:24
ds_read2_b32 v[12:13], v4 offset0:32 offset1:40
ds_read2_b32 v[14:15], v4 offset0:48 offset1:56
s_setprio 1
s_sub_i32 s21, s21, 1
s_waitcnt vmcnt(4) lgkmcnt(8)
v_dot2_f32_bf16 v80, v16, v48, 0
v_dot2_f32_bf16 v81, v20, v52, 0
v_dot2_f32_bf16 v82, v24, v56, 0
v_dot2_f32_bf16 v83, v28, v60, 0
v_dot2_f32_bf16 v80, v17, v49, v80
v_dot2_f32_bf16 v81, v21, v53, v81
v_dot2_f32_bf16 v82, v25, v57, v82
v_dot2_f32_bf16 v83, v29, v61, v83
v_dot2_f32_bf16 v80, v18, v50, v80
v_dot2_f32_bf16 v81, v22, v54, v81
v_dot2_f32_bf16 v82, v26, v58, v82
v_dot2_f32_bf16 v83, v30, v62, v83
v_dot2_f32_bf16 v80, v19, v51, v80
v_dot2_f32_bf16 v81, v23, v55, v81
v_dot2_f32_bf16 v82, v27, v59, v82
v_dot2_f32_bf16 v83, v31, v63, v83
s_waitcnt vmcnt(0) lgkmcnt(4)
v_dot2_f32_bf16 v84, v32, v64, 0
v_dot2_f32_bf16 v85, v36, v68, 0
v_dot2_f32_bf16 v86, v40, v72, 0
v_dot2_f32_bf16 v87, v44, v76, 0
v_dot2_f32_bf16 v84, v33, v65, v84
v_dot2_f32_bf16 v85, v37, v69, v85
v_dot2_f32_bf16 v86, v41, v73, v86
v_dot2_f32_bf16 v87, v45, v77, v87
v_dot2_f32_bf16 v84, v34, v66, v84
v_dot2_f32_bf16 v85, v38, v70, v85
v_dot2_f32_bf16 v86, v42, v74, v86
v_dot2_f32_bf16 v87, v46, v78, v87
v_dot2_f32_bf16 v84, v35, v67, v84
v_dot2_f32_bf16 v85, v39, v71, v85
v_dot2_f32_bf16 v86, v43, v75, v86
v_dot2_f32_bf16 v87, v47, v79, v87
v_pk_mov_b32 v[48:49], v[16:17], v[20:21] op_sel:[0,0]
v_pk_mov_b32 v[50:51], v[24:25], v[28:29] op_sel:[0,0]
v_pk_mov_b32 v[52:53], v[16:17], v[20:21] op_sel:[1,1]
v_pk_mov_b32 v[54:55], v[24:25], v[28:29] op_sel:[1,1]
v_pk_mov_b32 v[56:57], v[18:19], v[22:23] op_sel:[0,0]
v_pk_mov_b32 v[58:59], v[26:27], v[30:31] op_sel:[0,0]
v_pk_mov_b32 v[60:61], v[18:19], v[22:23] op_sel:[1,1]
v_pk_mov_b32 v[62:63], v[26:27], v[30:31] op_sel:[1,1]
v_pk_mov_b32 v[64:65], v[32:33], v[36:37] op_sel:[0,0]
v_pk_mov_b32 v[66:67], v[40:41], v[44:45] op_sel:[0,0]
v_pk_mov_b32 v[68:69], v[32:33], v[36:37] op_sel:[1,1]
v_pk_mov_b32 v[70:71], v[40:41], v[44:45] op_sel:[1,1]
v_pk_mov_b32 v[72:73], v[34:35], v[38:39] op_sel:[0,0]
v_pk_mov_b32 v[74:75], v[42:43], v[46:47] op_sel:[0,0]
v_pk_mov_b32 v[76:77], v[34:35], v[38:39] op_sel:[1,1]
v_pk_mov_b32 v[78:79], v[42:43], v[46:47] op_sel:[1,1]
v_add_f32_dpp v80, v80, v80 row_half_mirror row_mask:0xf bank_mask:0x5
v_add_f32_dpp v81, v81, v81 row_half_mirror row_mask:0xf bank_mask:0x5
v_add_f32_dpp v82, v82, v82 row_half_mirror row_mask:0xf bank_mask:0x5
v_add_f32_dpp v83, v83, v83 row_half_mirror row_mask:0xf bank_mask:0x5
v_add_f32_dpp v80, v84, v84 row_half_mirror row_mask:0xf bank_mask:0xa
v_add_f32_dpp v81, v85, v85 row_half_mirror row_mask:0xf bank_mask:0xa
v_add_f32_dpp v82, v86, v86 row_half_mirror row_mask:0xf bank_mask:0xa
v_add_f32_dpp v83, v87, v87 row_half_mirror row_mask:0xf bank_mask:0xa
v_bitop3_b32 v7, v7, 48, v2 bitop3:0x6a
v_add_f32_dpp v84, v80, v80 quad_perm:[2,3,0,1] row_mask:0xf bank_mask:0xf
v_add_f32_dpp v85, v81, v81 quad_perm:[2,3,0,1] row_mask:0xf bank_mask:0xf
v_add_f32_dpp v86, v82, v82 quad_perm:[2,3,0,1] row_mask:0xf bank_mask:0xf
v_add_f32_dpp v87, v83, v83 quad_perm:[2,3,0,1] row_mask:0xf bank_mask:0xf
v_cndmask_b32 v80, v84, v86, s[30:31]
v_cndmask_b32 v81, v85, v87, s[30:31]
s_nop 0
v_add_f32_dpp v82, v80, v80 quad_perm:[1,0,3,2] row_mask:0xf bank_mask:0xf
v_add_f32_dpp v83, v81, v81 quad_perm:[1,0,3,2] row_mask:0xf bank_mask:0xf
v_cndmask_b32 v84, v82, v83, s[32:33]
v_mul_f32 v84, s28, v84
v_exp_f32 v84, v84
s_nop 0
v_add_f32 v84, 1.0, v84
v_rcp_f32 v84, v84
s_nop 0
v_cvt_pk_bf16_f32 v85, v84, 0
v_cvt_pk_bf16_f32 v84, 0, v84
ds_write2_b32 v7, v85, v84 offset0:0 offset1:16
ds_read_b128 v[16:19], v3
ds_read_b128 v[20:23], v3 offset:1088
ds_write2_b32 v7, v6, v6 offset0:0 offset1:16
ds_read_b32 v7, v5
s_waitcnt lgkmcnt(3)
v_mfma_f32_16x16x32_bf16 v[112:115], v[48:51], v[16:19], v[112:115]
v_mfma_f32_16x16x32_bf16 v[116:119], v[52:55], v[16:19], v[116:119]
v_mfma_f32_16x16x32_bf16 v[120:123], v[56:59], v[16:19], v[120:123]
v_mfma_f32_16x16x32_bf16 v[124:127], v[60:63], v[16:19], v[124:127]
s_waitcnt lgkmcnt(2)
v_mfma_f32_16x16x32_bf16 v[112:115], v[64:67], v[20:23], v[112:115]
v_mfma_f32_16x16x32_bf16 v[116:119], v[68:71], v[20:23], v[116:119]
v_mfma_f32_16x16x32_bf16 v[120:123], v[72:75], v[20:23], v[120:123]
v_mfma_f32_16x16x32_bf16 v[124:127], v[76:79], v[20:23], v[124:127]
s_cmp_lt_i32 s21, 0
s_cbranch_scc1 G_nonextc
v_xor_b32 v16, v8, v0
v_xor_b32 v20, v9, v0
v_xor_b32 v24, v10, v0
v_xor_b32 v28, v11, v0
v_xor_b32 v32, v12, v0
v_xor_b32 v36, v13, v0
v_xor_b32 v40, v14, v0
v_xor_b32 v44, v15, v0
buffer_load_dwordx4 v[16:19], v16, s[4:7], 0 offen
buffer_load_dwordx4 v[20:23], v20, s[4:7], 0 offen
buffer_load_dwordx4 v[24:27], v24, s[4:7], 0 offen
buffer_load_dwordx4 v[28:31], v28, s[4:7], 0 offen
buffer_load_dwordx4 v[32:35], v32, s[4:7], 0 offen
buffer_load_dwordx4 v[36:39], v36, s[4:7], 0 offen
buffer_load_dwordx4 v[40:43], v40, s[4:7], 0 offen
buffer_load_dwordx4 v[44:47], v44, s[4:7], 0 offen
v_mad_legacy_u16 v8, v8, s24, v1
v_mad_legacy_u16 v9, v9, s24, v1
v_mad_legacy_u16 v10, v10, s24, v1
v_mad_legacy_u16 v11, v11, s24, v1
v_mad_legacy_u16 v12, v12, s24, v1
v_mad_legacy_u16 v13, v13, s24, v1
v_mad_legacy_u16 v14, v14, s24, v1
v_mad_legacy_u16 v15, v15, s24, v1
G_nonextc:
s_cmp_lt_i32 s21, 0
s_cbranch_scc1 G_done
G_loop:
ds_read_b128 v[48:51], v8 offset:0
ds_read_b128 v[52:55], v9 offset:0
ds_read_b128 v[56:59], v10 offset:0
ds_read_b128 v[60:63], v11 offset:0
ds_read_b128 v[64:67], v12 offset:0
ds_read_b128 v[68:71], v13 offset:0
ds_read_b128 v[72:75], v14 offset:0
ds_read_b128 v[76:79], v15 offset:0
v_subrev_u32 v4, 0x100, v4
v_subrev_u32 v5, 0x100, v5
ds_read2_b32 v[8:9], v4 offset0:0 offset1:8
ds_read2_b32 v[10:11], v4 offset0:16 offset1:24
ds_read2_b32 v[12:13], v4 offset0:32 offset1:40
ds_read2_b32 v[14:15], v4 offset0:48 offset1:56
s_setprio 0
s_sub_i32 s21, s21, 1
s_waitcnt vmcnt(4) lgkmcnt(8)
v_dot2_f32_bf16 v80, v16, v48, 0
v_dot2_f32_bf16 v81, v20, v52, 0
v_dot2_f32_bf16 v82, v24, v56, 0
v_dot2_f32_bf16 v83, v28, v60, 0
v_dot2_f32_bf16 v80, v17, v49, v80
v_dot2_f32_bf16 v81, v21, v53, v81
v_dot2_f32_bf16 v82, v25, v57, v82
v_dot2_f32_bf16 v83, v29, v61, v83
v_dot2_f32_bf16 v80, v18, v50, v80
v_dot2_f32_bf16 v81, v22, v54, v81
v_dot2_f32_bf16 v82, v26, v58, v82
v_dot2_f32_bf16 v83, v30, v62, v83
v_dot2_f32_bf16 v80, v19, v51, v80
v_dot2_f32_bf16 v81, v23, v55, v81
v_dot2_f32_bf16 v82, v27, v59, v82
v_dot2_f32_bf16 v83, v31, v63, v83
s_waitcnt vmcnt(0) lgkmcnt(4)
v_dot2_f32_bf16 v84, v32, v64, 0
v_dot2_f32_bf16 v85, v36, v68, 0
v_dot2_f32_bf16 v86, v40, v72, 0
v_dot2_f32_bf16 v87, v44, v76, 0
v_dot2_f32_bf16 v84, v33, v65, v84
v_dot2_f32_bf16 v85, v37, v69, v85
v_dot2_f32_bf16 v86, v41, v73, v86
v_dot2_f32_bf16 v87, v45, v77, v87
v_dot2_f32_bf16 v84, v34, v66, v84
v_dot2_f32_bf16 v85, v38, v70, v85
v_dot2_f32_bf16 v86, v42, v74, v86
v_dot2_f32_bf16 v87, v46, v78, v87
v_dot2_f32_bf16 v84, v35, v67, v84
v_dot2_f32_bf16 v85, v39, v71, v85
v_dot2_f32_bf16 v86, v43, v75, v86
v_dot2_f32_bf16 v87, v47, v79, v87
v_pk_mov_b32 v[48:49], v[16:17], v[20:21] op_sel:[0,0]
v_pk_mov_b32 v[50:51], v[24:25], v[28:29] op_sel:[0,0]
v_pk_mov_b32 v[52:53], v[16:17], v[20:21] op_sel:[1,1]
v_pk_mov_b32 v[54:55], v[24:25], v[28:29] op_sel:[1,1]
v_pk_mov_b32 v[56:57], v[18:19], v[22:23] op_sel:[0,0]
v_pk_mov_b32 v[58:59], v[26:27], v[30:31] op_sel:[0,0]
v_pk_mov_b32 v[60:61], v[18:19], v[22:23] op_sel:[1,1]
v_pk_mov_b32 v[62:63], v[26:27], v[30:31] op_sel:[1,1]
v_pk_mov_b32 v[64:65], v[32:33], v[36:37] op_sel:[0,0]
v_pk_mov_b32 v[66:67], v[40:41], v[44:45] op_sel:[0,0]
v_pk_mov_b32 v[68:69], v[32:33], v[36:37] op_sel:[1,1]
v_pk_mov_b32 v[70:71], v[40:41], v[44:45] op_sel:[1,1]
v_pk_mov_b32 v[72:73], v[34:35], v[38:39] op_sel:[0,0]
v_pk_mov_b32 v[74:75], v[42:43], v[46:47] op_sel:[0,0]
v_pk_mov_b32 v[76:77], v[34:35], v[38:39] op_sel:[1,1]
v_pk_mov_b32 v[78:79], v[42:43], v[46:47] op_sel:[1,1]
v_add_f32_dpp v80, v80, v80 row_half_mirror row_mask:0xf bank_mask:0x5
v_add_f32_dpp v81, v81, v81 row_half_mirror row_mask:0xf bank_mask:0x5
v_add_f32_dpp v82, v82, v82 row_half_mirror row_mask:0xf bank_mask:0x5
v_add_f32_dpp v83, v83, v83 row_half_mirror row_mask:0xf bank_mask:0x5
v_add_f32_dpp v80, v84, v84 row_half_mirror row_mask:0xf bank_mask:0xa
v_add_f32_dpp v81, v85, v85 row_half_mirror row_mask:0xf bank_mask:0xa
v_add_f32_dpp v82, v86, v86 row_half_mirror row_mask:0xf bank_mask:0xa
v_add_f32_dpp v83, v87, v87 row_half_mirror row_mask:0xf bank_mask:0xa
v_bitop3_b32 v7, v7, 48, v2 bitop3:0x6a
v_add_f32_dpp v84, v80, v80 quad_perm:[2,3,0,1] row_mask:0xf bank_mask:0xf
v_add_f32_dpp v85, v81, v81 quad_perm:[2,3,0,1] row_mask:0xf bank_mask:0xf
v_add_f32_dpp v86, v82, v82 quad_perm:[2,3,0,1] row_mask:0xf bank_mask:0xf
v_add_f32_dpp v87, v83, v83 quad_perm:[2,3,0,1] row_mask:0xf bank_mask:0xf
v_cndmask_b32 v80, v84, v86, s[30:31]
v_cndmask_b32 v81, v85, v87, s[30:31]
s_nop 0
v_add_f32_dpp v82, v80, v80 quad_perm:[1,0,3,2] row_mask:0xf bank_mask:0xf
v_add_f32_dpp v83, v81, v81 quad_perm:[1,0,3,2] row_mask:0xf bank_mask:0xf
v_cndmask_b32 v84, v82, v83, s[32:33]
v_mul_f32 v84, s28, v84
v_exp_f32 v84, v84
s_nop 0
v_add_f32 v84, 1.0, v84
v_rcp_f32 v84, v84
s_nop 0
v_cvt_pk_bf16_f32 v85, v84, 0
v_cvt_pk_bf16_f32 v84, 0, v84
ds_write2_b32 v7, v85, v84 offset0:0 offset1:16
ds_read_b128 v[16:19], v3
ds_read_b128 v[20:23], v3 offset:1088
ds_write2_b32 v7, v6, v6 offset0:0 offset1:16
ds_read_b32 v7, v5
s_waitcnt lgkmcnt(3)
v_mfma_f32_16x16x32_bf16 v[112:115], v[48:51], v[16:19], v[112:115]
v_mfma_f32_16x16x32_bf16 v[116:119], v[52:55], v[16:19], v[116:119]
v_mfma_f32_16x16x32_bf16 v[120:123], v[56:59], v[16:19], v[120:123]
v_mfma_f32_16x16x32_bf16 v[124:127], v[60:63], v[16:19], v[124:127]
s_waitcnt lgkmcnt(2)
v_mfma_f32_16x16x32_bf16 v[112:115], v[64:67], v[20:23], v[112:115]
v_mfma_f32_16x16x32_bf16 v[116:119], v[68:71], v[20:23], v[116:119]
v_mfma_f32_16x16x32_bf16 v[120:123], v[72:75], v[20:23], v[120:123]
v_mfma_f32_16x16x32_bf16 v[124:127], v[76:79], v[20:23], v[124:127]
s_cmp_lt_i32 s21, 0
s_cbranch_scc1 G_nonextd
v_xor_b32 v16, v8, v0
v_xor_b32 v20, v9, v0
v_xor_b32 v24, v10, v0
v_xor_b32 v28, v11, v0
v_xor_b32 v32, v12, v0
v_xor_b32 v36, v13, v0
v_xor_b32 v40, v14, v0
v_xor_b32 v44, v15, v0
buffer_load_dwordx4 v[16:19], v16, s[4:7], 0 offen
buffer_load_dwordx4 v[20:23], v20, s[4:7], 0 offen
buffer_load_dwordx4 v[24:27], v24, s[4:7], 0 offen
buffer_load_dwordx4 v[28:31], v28, s[4:7], 0 offen
buffer_load_dwordx4 v[32:35], v32, s[4:7], 0 offen
buffer_load_dwordx4 v[36:39], v36, s[4:7], 0 offen
buffer_load_dwordx4 v[40:43], v40, s[4:7], 0 offen
buffer_load_dwordx4 v[44:47], v44, s[4:7], 0 offen
v_mad_legacy_u16 v8, v8, s24, v1
v_mad_legacy_u16 v9, v9, s24, v1
v_mad_legacy_u16 v10, v10, s24, v1
v_mad_legacy_u16 v11, v11, s24, v1
v_mad_legacy_u16 v12, v12, s24, v1
v_mad_legacy_u16 v13, v13, s24, v1
v_mad_legacy_u16 v14, v14, s24, v1
v_mad_legacy_u16 v15, v15, s24, v1
G_nonextd:
s_cmp_ge_i32 s21, 0
s_cbranch_scc1 G_loop
G_done:
s_cmp_lg_u32 s23, 0
s_cbranch_scc1 G_slownext
G_epi:
s_setprio 3
s_nop 4
v_permlane32_swap_b32 v112, v114
v_permlane32_swap_b32 v113, v115
v_permlane32_swap_b32 v116, v118
v_permlane32_swap_b32 v117, v119
v_permlane32_swap_b32 v120, v122
v_permlane32_swap_b32 v121, v123
v_permlane32_swap_b32 v124, v126
v_permlane32_swap_b32 v125, v127
v_add_f32_dpp v112, v114, v112 row_ror:8 row_mask:0xf bank_mask:0xf
v_add_f32_dpp v113, v115, v113 row_ror:8 row_mask:0xf bank_mask:0xf
v_add_f32_dpp v116, v118, v116 row_ror:8 row_mask:0xf bank_mask:0xf
v_add_f32_dpp v117, v119, v117 row_ror:8 row_mask:0xf bank_mask:0xf
v_add_f32_dpp v120, v122, v120 row_ror:8 row_mask:0xf bank_mask:0xf
v_add_f32_dpp v121, v123, v121 row_ror:8 row_mask:0xf bank_mask:0xf
v_add_f32_dpp v124, v126, v124 row_ror:8 row_mask:0xf bank_mask:0xf
v_add_f32_dpp v125, v127, v125 row_ror:8 row_mask:0xf bank_mask:0xf
v_xor_b32 v21, 16, v104
v_cvt_pk_bf16_f32 v24, v112, v116
v_cvt_pk_bf16_f32 v25, v120, v124
v_cvt_pk_bf16_f32 v26, v113, v117
v_cvt_pk_bf16_f32 v27, v121, v125
s_mov_b32 exec_lo, 0x00770077
s_mov_b32 exec_hi, 0x00770077
ds_write_b64 v104, v[24:25]
ds_write_b64 v21, v[26:27]
s_mov_b64 exec, -1
v_xor_b32 v29, 64, v105
s_sub_u32 s36, s17, 8
s_waitcnt lgkmcnt(0)
s_barrier
s_cmp_ge_u32 s36, 6
s_cbranch_scc1 G_fin
ds_read_b128 v[48:51], v105
ds_read_b128 v[52:55], v29
s_mul_i32 s34, s16, 5120
s_waitcnt lgkmcnt(1)
v_mfma_f32_16x16x32_bf16 v[56:59], v[88:91], v[48:51], 0
v_mfma_f32_16x16x32_bf16 v[60:63], v[96:99], v[48:51], 0
s_waitcnt lgkmcnt(0)
v_mfma_f32_16x16x32_bf16 v[56:59], v[92:95], v[52:55], v[56:59]
v_mfma_f32_16x16x32_bf16 v[60:63], v[100:103], v[52:55], v[60:63]
s_nop 5
s_cmp_lt_u32 s36, 4
s_cbranch_scc1 G_nosum
v_add_f32_dpp v56, v56, v56 row_ror:8 row_mask:0xf bank_mask:0xf
v_add_f32_dpp v57, v57, v57 row_ror:8 row_mask:0xf bank_mask:0xf
v_add_f32_dpp v58, v58, v58 row_ror:8 row_mask:0xf bank_mask:0xf
v_add_f32_dpp v59, v59, v59 row_ror:8 row_mask:0xf bank_mask:0xf
v_add_f32_dpp v60, v60, v60 row_ror:8 row_mask:0xf bank_mask:0xf
v_add_f32_dpp v61, v61, v61 row_ror:8 row_mask:0xf bank_mask:0xf
v_add_f32_dpp v62, v62, v62 row_ror:8 row_mask:0xf bank_mask:0xf
v_add_f32_dpp v63, v63, v63 row_ror:8 row_mask:0xf bank_mask:0xf
s_mov_b32 exec_lo, 0x00ff00ff
s_mov_b32 exec_hi, 0x00ff00ff
G_nosum:
v_cvt_pk_bf16_f32 v64, v56, v57
v_cvt_pk_bf16_f32 v65, v58, v59
v_cvt_pk_bf16_f32 v66, v60, v61
v_cvt_pk_bf16_f32 v67, v62, v63
buffer_store_dwordx4 v[64:67], v106, s[12:15], s34 offen sc1
G_fin:
G_end:
s_endpgm
G_slow:
s_mov_b32 s23, 1
s_mov_b32 s27, 0
v_mov_b32 v112, 0
v_mov_b32 v113, 0
v_mov_b32 v114, 0
v_mov_b32 v115, 0
v_mov_b32 v116, 0
v_mov_b32 v117, 0
v_mov_b32 v118, 0
v_mov_b32 v119, 0
v_mov_b32 v120, 0
v_mov_b32 v121, 0
v_mov_b32 v122, 0
v_mov_b32 v123, 0
v_mov_b32 v124, 0
v_mov_b32 v125, 0
v_mov_b32 v126, 0
v_mov_b32 v127, 0
s_mov_b32 s54, 0
s_mov_b32 s55, 0
s_waitcnt vmcnt(0) lgkmcnt(0)
s_barrier
v_mbcnt_lo_u32_b32 v17, -1, 0
v_mbcnt_hi_u32_b32 v17, -1, v17
s_lshl_b32 s34, s17, 6
v_add_u32 v16, s34, v17
v_lshrrev_b32 v36, 2, v16
v_mul_u32_u24 v36, 28416, v36
v_and_b32 v37, 3, v16
v_lshl_add_u32 v33, v37, 4, v36
buffer_load_dwordx4 v[60:63], v33, s[8:11], s3 offen sc1
s_mov_b64 s[40:41], -1
s_cmp_lg_u32 s17, 15
s_cselect_b32 s41, -1, 0xff
s_mov_b32 s42, 0x200000
s_waitcnt vmcnt(0)
v_xor_b32 v60, s56, v60
v_xor_b32 v61, s57, v61
v_xor_b32 v62, s58, v62
v_xor_b32 v63, s59, v63
s_nop 0
s_nop 0
v_mov_b32_dpp v56, v63 quad_perm:[3,3,3,3] row_mask:0xf bank_mask:0xf
v_cmp_ne_u32 vcc, s43, v56
v_lshrrev_b32 v57, 10, v56
v_and_b32 v56, 0x3ff, v56
s_and_b64 vcc, vcc, s[40:41]
v_lshl_add_u32 v56, v56, 4, v33
v_cndmask_b32 v57, 0, v57, vcc
v_mov_b32 v58, 84096
s_cmp_lg_u32 s17, 0
s_cbranch_scc1 G_slow0
ds_write_b32 v58, v6
G_slow0:
s_waitcnt vmcnt(0) lgkmcnt(0)
s_barrier
ds_max_u32 v58, v57
s_waitcnt lgkmcnt(0)
s_barrier
ds_read_b32 v35, v58
s_waitcnt lgkmcnt(0)
v_readfirstlane_b32 s45, v35
s_nop 3
s_add_u32 s45, s45, 4
s_branch G_slowround
G_slownext:
s_waitcnt vmcnt(0) lgkmcnt(0)
s_barrier
s_add_u32 s55, s55, 1
s_cmp_lt_u32 s55, 16
s_cbranch_scc1 G_slowround
s_mov_b32 s55, 0
s_add_u32 s54, s54, 4
s_cmp_ge_u32 s54, s45
s_cbranch_scc1 G_epi
G_slowround:
v_mbcnt_lo_u32_b32 v17, -1, 0
v_mbcnt_hi_u32_b32 v17, -1, v17
s_lshl_b32 s34, s17, 6
v_add_u32 v16, s34, v17
v_lshlrev_b32 v36, 4, v16
v_add_u32 v36, 84480, v36
v_mov_b32 v68, 2096944
v_mov_b32 v69, 2096944
v_mov_b32 v70, 2096944
v_mov_b32 v71, 2096944
ds_write_b128 v36, v[68:71]
ds_write_b128 v36, v[68:71] offset:4096
v_and_b32 v59, 15, v17
v_lshlrev_b32 v59, 2, v59
v_add_u32 v59, 83968, v59
ds_write_b32 v59, v6
s_waitcnt lgkmcnt(0)
s_barrier
s_cmp_lg_u32 s17, s55
s_cbranch_scc1 G_slow2
v_lshrrev_b32 v36, 2, v16
v_mul_u32_u24 v36, 28416, v36
v_and_b32 v37, 3, v16
v_lshl_add_u32 v33, v37, 4, v36
buffer_load_dwordx4 v[60:63], v33, s[8:11], s3 offen sc1
s_mov_b64 s[40:41], -1
s_cmp_lg_u32 s17, 15
s_cselect_b32 s41, -1, 0xff
s_mov_b32 s42, 0x200000
s_waitcnt vmcnt(0)
v_xor_b32 v60, s56, v60
v_xor_b32 v61, s57, v61
v_xor_b32 v62, s58, v62
v_xor_b32 v63, s59, v63
s_nop 0
s_nop 0
v_mov_b32_dpp v56, v63 quad_perm:[3,3,3,3] row_mask:0xf bank_mask:0xf
v_cmp_ne_u32 vcc, s43, v56
v_lshrrev_b32 v57, 10, v56
v_and_b32 v56, 0x3ff, v56
s_and_b64 vcc, vcc, s[40:41]
v_lshl_add_u32 v56, v56, 4, v33
v_cndmask_b32 v57, 0, v57, vcc
v_mov_b32 v39, 1
v_mov_b32 v58, 83968
s_cmp_lg_u32 s54, 0
s_cbranch_scc1 G_slowov
v_cmp_ne_u32 s[46:47], s43, v60
v_cmp_ne_u32 s[48:49], s43, v61
v_cmp_ne_u32 s[50:51], s43, v62
v_cmp_ne_u32 s[52:53], s43, v63
v_and_b32 v80, 15, v60
v_and_b32 v81, 15, v61
v_and_b32 v82, 15, v62
v_and_b32 v83, 15, v63
v_lshl_add_u32 v84, v80, 2, v58
v_lshl_add_u32 v85, v81, 2, v58
v_lshl_add_u32 v86, v82, 2, v58
v_lshl_add_u32 v87, v83, 2, v58
s_and_b32 s52, s52, 0x77777777
s_and_b32 s53, s53, 0x77777777
s_and_b64 s[46:47], s[46:47], s[40:41]
s_mov_b64 exec, s[46:47]
ds_add_rtn_u32 v68, v84, v39
s_and_b64 s[48:49], s[48:49], s[40:41]
s_mov_b64 exec, s[48:49]
ds_add_rtn_u32 v69, v85, v39
s_and_b64 s[50:51], s[50:51], s[40:41]
s_mov_b64 exec, s[50:51]
ds_add_rtn_u32 v70, v86, v39
s_and_b64 s[52:53], s[52:53], s[40:41]
s_mov_b64 exec, s[52:53]
ds_add_rtn_u32 v71, v87, v39
s_mov_b64 exec, -1
v_mad_u32_u24 v80, v80, s29, v58
v_mad_u32_u24 v81, v81, s29, v58
v_mad_u32_u24 v82, v82, s29, v58
v_mad_u32_u24 v83, v83, s29, v58
s_waitcnt lgkmcnt(3)
v_lshl_add_u32 v80, v68, 2, v80
s_mov_b64 exec, s[46:47]
ds_write_b32 v80, v60 offset:512
s_mov_b64 exec, -1
s_waitcnt lgkmcnt(3)
v_lshl_add_u32 v81, v69, 2, v81
s_mov_b64 exec, s[48:49]
ds_write_b32 v81, v61 offset:512
s_mov_b64 exec, -1
s_waitcnt lgkmcnt(3)
v_lshl_add_u32 v82, v70, 2, v82
s_mov_b64 exec, s[50:51]
ds_write_b32 v82, v62 offset:512
s_mov_b64 exec, -1
s_waitcnt lgkmcnt(3)
v_lshl_add_u32 v83, v71, 2, v83
s_mov_b64 exec, s[52:53]
ds_write_b32 v83, v63 offset:512
s_mov_b64 exec, -1
s_branch G_slow2
G_slowov:
s_sub_u32 s34, s54, 4
v_add_u32 v37, s34, v37
v_cmp_lt_u32 s[38:39], v37, v57
s_lshl_b32 s36, s34, 4
s_add_u32 s36, s36, 16000
v_mov_b32 v38, 0x40000000
v_cndmask_b32 v56, v38, v56, s[38:39]
s_mov_b32 s34, 0x200000
G_spoll:
buffer_load_dwordx4 v[64:67], v56, s[8:11], s36 offen sc1
s_waitcnt vmcnt(0)
v_xor_b32 v64, s56, v64
v_xor_b32 v65, s57, v65
v_xor_b32 v66, s58, v66
v_xor_b32 v67, s59, v67
v_or3_b32 v57, v64, v65, v66
v_or_b32 v57, v57, v67
v_cmp_le_u32 vcc, s42, v57
s_nop 1
s_and_b64 vcc, vcc, s[38:39]
s_cbranch_scc0 G_spolld
s_sub_u32 s34, s34, 1
s_cmp_lg_u32 s34, 0
s_cbranch_scc1 G_spoll
G_spolld:
v_cmp_ne_u32 s[46:47], s43, v64
v_cmp_ne_u32 s[48:49], s43, v65
v_cmp_ne_u32 s[50:51], s43, v66
v_cmp_ne_u32 s[52:53], s43, v67
v_and_b32 v80, 15, v64
v_and_b32 v81, 15, v65
v_and_b32 v82, 15, v66
v_and_b32 v83, 15, v67
v_lshl_add_u32 v84, v80, 2, v58
v_lshl_add_u32 v85, v81, 2, v58
v_lshl_add_u32 v86, v82, 2, v58
v_lshl_add_u32 v87, v83, 2, v58
s_and_b64 s[46:47], s[46:47], s[38:39]
s_mov_b64 exec, s[46:47]
ds_add_rtn_u32 v68, v84, v39
s_and_b64 s[48:49], s[48:49], s[38:39]
s_mov_b64 exec, s[48:49]
ds_add_rtn_u32 v69, v85, v39
s_and_b64 s[50:51], s[50:51], s[38:39]
s_mov_b64 exec, s[50:51]
ds_add_rtn_u32 v70, v86, v39
s_and_b64 s[52:53], s[52:53], s[38:39]
s_mov_b64 exec, s[52:53]
ds_add_rtn_u32 v71, v87, v39
s_mov_b64 exec, -1
v_mad_u32_u24 v80, v80, s29, v58
v_mad_u32_u24 v81, v81, s29, v58
v_mad_u32_u24 v82, v82, s29, v58
v_mad_u32_u24 v83, v83, s29, v58
s_waitcnt lgkmcnt(3)
v_lshl_add_u32 v80, v68, 2, v80
s_mov_b64 exec, s[46:47]
ds_write_b32 v80, v64 offset:512
s_mov_b64 exec, -1
s_waitcnt lgkmcnt(3)
v_lshl_add_u32 v81, v69, 2, v81
s_mov_b64 exec, s[48:49]
ds_write_b32 v81, v65 offset:512
s_mov_b64 exec, -1
s_waitcnt lgkmcnt(3)
v_lshl_add_u32 v82, v70, 2, v82
s_mov_b64 exec, s[50:51]
ds_write_b32 v82, v66 offset:512
s_mov_b64 exec, -1
s_waitcnt lgkmcnt(3)
v_lshl_add_u32 v83, v71, 2, v83
s_mov_b64 exec, s[52:53]
ds_write_b32 v83, v67 offset:512
s_mov_b64 exec, -1
G_slow2:
s_mul_i32 s34, s17, 1280
s_add_u32 s34, s34, 84480
v_lshrrev_b32 v50, 3, v17
v_lshlrev_b32 v50, 2, v50
v_add_u32 v4, s34, v50
v_and_b32 v48, 7, v17
v_add_u32 v4, 0x200, v4
v_lshl_add_u32 v5, v48, 5, v4
s_movk_i32 s35, 320
s_waitcnt lgkmcnt(0)
s_barrier
s_branch G_round
.section .rodata,"a"
.p2align 6
.amdhsa_kernel gather_scatter__kernel_systems_refs_featgraph__graph_kernel
  .amdhsa_next_free_vgpr 128
  .amdhsa_next_free_sgpr 64
  .amdhsa_accum_offset 128
  .amdhsa_group_segment_fixed_size 0
  .amdhsa_kernarg_size 64
  .amdhsa_user_sgpr_count 2
  .amdhsa_user_sgpr_kernarg_segment_ptr 1
  .amdhsa_system_sgpr_workgroup_id_x 1
.end_amdhsa_kernel
```
